```python
import torch

def _softmax(x, axis=-1):
    return torch.softmax(x, dim=axis)
def _gelu(x):
    return torch.nn.functional.gelu(x, approximate="tanh")
def _silu(x):
    return torch.nn.functional.silu(x)
def _sigmoid(x):
    return torch.sigmoid(x)
def _layernorm(x, axis=-1, eps=1e-5):
    m = x.mean(dim=axis, keepdim=True)
    v = x.var(dim=axis, keepdim=True, unbiased=False)
    return (x - m) / torch.sqrt(v + eps)
def _scatter_add(tgt, idx, src, axis=0):
    return tgt.clone().index_add_(axis, idx, src)
def _segment_sum(src, seg, n):
    out = torch.zeros((n,) + src.shape[1:], dtype=src.dtype)
    return out.index_add_(0, seg, src)
def _pad(x, pw):
    flat = tuple(v for pair in reversed(pw) for v in pair)
    return torch.nn.functional.pad(x, flat)

kernel_name = 'standalone__mha_softmax__sampling'

def setup_inputs():

    _w = (lambda a: (lambda t: t.to(torch.bfloat16) if t.is_floating_point() else t)(torch.as_tensor(a)))
    B, H, Sq, Sk, D = 8, 16, 4, 4096, 256
    return {
        "q": _w((lambda *s: torch.randn(*s, dtype=torch.bfloat16) * 0.8)(B, H, Sq, D)),
        "k": _w((lambda *s: torch.randn(*s, dtype=torch.bfloat16) * 0.8)(B, H, Sk, D)),
        "v": _w((lambda *s: torch.randn(*s, dtype=torch.bfloat16) * 0.05)(B, H, Sk, D)),
    }

def reference(q, k, v):
    scale = q.shape[-1] ** -0.5
    scores = torch.einsum("bhqd,bhkd->bhqk", q, k) * scale
    p = _softmax(scores, axis=-1)
    return torch.einsum("bhqk,bhkd->bhqd", p, v)
```

```asm
; @launch grid=(256,1,1) block=(320,1,1) lds=33024
.amdgcn_target "amdgcn-amd-amdhsa--gfx950"
.text
.globl standalone__mha_softmax__sampling_kernel
.p2align 8
.type standalone__mha_softmax__sampling_kernel,@function
standalone__mha_softmax__sampling_kernel:
    s_cmp_ge_u32 s2, 256
    s_cbranch_scc1 L_end
    s_load_dwordx4 s[4:7], s[0:1], 0
    s_load_dwordx4 s[8:11], s[0:1], 16
    s_load_dwordx4 s[12:15], s[0:1], 32
    v_lshrrev_b32 v7, 6, v0
    v_and_b32 v0, 63, v0
    v_readfirstlane_b32 s36, v7
    v_lshrrev_b32 v9, 4, v0
    v_and_b32 v10, 3, v0
    v_bfe_u32 v11, v0, 2, 2
    v_lshlrev_b32 v1, 9, v11
    v_lshl_add_u32 v1, v9, 6, v1
    v_lshl_add_u32 v1, v10, 4, v1
    s_bfe_u32 s49, s2, 0x10000
    s_bfe_u32 s42, s2, 0x10001
    s_lshl_b32 s41, s42, 6
    s_bfe_u32 s42, s2, 0x10002
    s_lshl_b32 s42, s42, 2
    s_or_b32 s41, s41, s42
    s_bfe_u32 s42, s2, 0x20003
    s_lshl_b32 s42, s42, 0
    s_or_b32 s41, s41, s42
    s_bfe_u32 s42, s2, 0x30005
    s_lshl_b32 s42, s42, 3
    s_or_b32 s41, s41, s42
    s_cmp_eq_u32 s36, 4
    s_cbranch_scc1 L_helper
    s_lshl_b32 s43, s41, 21
    s_lshl_b32 s44, s41, 11
    s_lshl_b32 s45, s49, 14
    s_lshl_b32 s46, s36, 12
    s_add_u32 s68, s45, s46
    s_add_u32 s56, s68, 0
    s_add_u32 s57, s68, 32768
    s_add_u32 s58, s68, 65536
    s_add_u32 s59, s68, 98304
    s_mov_b32 s18, 0x200000
    s_mov_b32 s19, 0x20000
    s_mov_b32 s22, 0x200000
    s_mov_b32 s23, 0x20000
    s_mov_b32 s26, 0x800
    s_mov_b32 s27, 0x20000
    s_mov_b64 vcc, 0
    s_mov_b32 s70, 0
    s_waitcnt lgkmcnt(0)
    s_add_u32 s16, s6, s43
    s_addc_u32 s17, s7, 0
    s_add_u32 s24, s4, s44
    s_addc_u32 s25, s5, 0
    buffer_load_dwordx4 v[80:83], v1, s[24:27], 0 offen offset:0
    buffer_load_dwordx4 v[84:87], v1, s[24:27], 0 offen offset:256
    buffer_load_dwordx4 v[152:155], v1, s[16:19], s56 offen offset:0 nt
    buffer_load_dwordx4 v[156:159], v1, s[16:19], s56 offen offset:256 nt
    buffer_load_dwordx4 v[160:163], v1, s[16:19], s56 offen offset:2048 nt
    buffer_load_dwordx4 v[164:167], v1, s[16:19], s56 offen offset:2304 nt
    buffer_load_dwordx4 v[168:171], v1, s[16:19], s57 offen offset:0 nt
    s_add_u32 s20, s8, s43
    s_addc_u32 s21, s9, 0
    v_and_b32 v8, 15, v0
    v_lshlrev_b32 v2, 9, v9
    v_lshl_add_u32 v2, v8, 4, v2
    s_mov_b32 s38, 0x3db8aa3b
    s_mov_b32 s39, 0x05040100
    s_mov_b32 s40, 0x07060302
    s_mov_b32 s60, 0x11111111
    s_mov_b32 s61, 0x11111111
    s_mov_b32 s62, 0x22222222
    s_mov_b32 s63, 0x22222222
    s_mov_b32 s64, 0x44444444
    s_mov_b32 s65, 0x44444444
    s_mov_b32 s66, 0x88888888
    s_mov_b32 s67, 0x88888888
    v_mov_b32 v3, 0xff800000
    v_mov_b32 v4, 0
    v_mov_b32 v64, 0
    v_mov_b32 v65, 0
    v_mov_b32 v66, 0
    v_mov_b32 v67, 0
    v_mov_b32 v68, 0
    v_mov_b32 v69, 0
    v_mov_b32 v70, 0
    v_mov_b32 v71, 0
    v_mov_b32 v72, 0
    v_mov_b32 v73, 0
    v_mov_b32 v74, 0
    v_mov_b32 v75, 0
    v_mov_b32 v76, 0
    v_mov_b32 v77, 0
    v_mov_b32 v78, 0
    v_mov_b32 v79, 0
    s_lshl_b32 s42, s36, 13
    s_add_u32 s42, s42, 256
    v_lshrrev_b32 v8, 2, v0
    v_lshl_add_u32 v216, v8, 5, s42
    v_mov_b32 v217, v216
    v_mul_u32_u24 v8, 388, v11
    v_mul_u32_u24 v7, 48, v9
    v_add3_u32 v8, v8, v7, v10
    v_lshl_add_u32 v220, v8, 2, s42
    s_lshl_b32 s42, s36, 2
    v_lshl_add_u32 v219, v11, 4, s42
    s_lshl_b32 s42, s36, 4
    v_mov_b32 v222, s42
    v_mov_b32 v221, 0
    v_mov_b32 v223, 0
    v_mov_b32 v224, 0
    s_barrier
    s_cbranch_vccnz L_s0
    s_waitcnt vmcnt(4)
L_s0:
    s_waitcnt vmcnt(5)
    buffer_load_dwordx4 v[172:175], v1, s[16:19], s57 offen offset:256 nt
    s_waitcnt lgkmcnt(0)
    v_readfirstlane_b32 s70, v223
    v_add_u32 v221, 1, v221
    s_cmp_eq_u32 s70, 1
    s_cselect_b64 vcc, -1, 0
    ds_write_b32 v222, v221
    ds_read_b32 v223, v222 offset:4
    s_cbranch_vccnz L_s1
    s_waitcnt vmcnt(4)
L_s1:
    s_waitcnt vmcnt(5)
    buffer_load_dwordx4 v[176:179], v1, s[16:19], s57 offen offset:2048 nt
    s_cbranch_vccnz L_s2
    s_waitcnt vmcnt(4)
L_s2:
    s_waitcnt vmcnt(5)
    buffer_load_dwordx4 v[180:183], v1, s[16:19], s57 offen offset:2304 nt
    s_waitcnt lgkmcnt(0)
    v_readfirstlane_b32 s70, v223
    v_add_u32 v221, 1, v221
    s_cmp_eq_u32 s70, 1
    s_cselect_b64 vcc, -1, 0
    ds_write_b32 v222, v221
    ds_read_b32 v223, v222 offset:4
    v_mfma_f32_16x16x32_bf16 v[20:23], v[152:155], v[80:83], 0
    v_mfma_f32_16x16x32_bf16 v[20:23], v[156:159], v[84:87], v[20:23]
    s_cbranch_vccnz L_s3
    s_waitcnt vmcnt(4)
L_s3:
    s_waitcnt vmcnt(5)
    buffer_load_dwordx4 v[184:187], v1, s[16:19], s58 offen offset:0 nt
    s_nop 4
    v_mov_b32_dpp v12, v20 quad_perm:[0,0,0,0] row_mask:0xf bank_mask:0xf
    v_add_f32_dpp v12, v21, v12 quad_perm:[1,1,1,1] row_mask:0xf bank_mask:0xf
    v_add_f32_dpp v12, v22, v12 quad_perm:[2,2,2,2] row_mask:0xf bank_mask:0xf
    v_add_f32_dpp v12, v23, v12 quad_perm:[3,3,3,3] row_mask:0xf bank_mask:0xf
    s_cbranch_vccnz L_s4
    s_waitcnt vmcnt(4)
L_s4:
    s_waitcnt vmcnt(5)
    buffer_load_dwordx4 v[188:191], v1, s[16:19], s58 offen offset:256 nt
    s_waitcnt lgkmcnt(0)
    v_readfirstlane_b32 s70, v223
    v_add_u32 v221, 1, v221
    s_cmp_eq_u32 s70, 1
    s_cselect_b64 vcc, -1, 0
    ds_write_b32 v222, v221
    ds_read_b32 v223, v222 offset:4
    v_mfma_f32_16x16x32_bf16 v[24:27], v[160:163], v[80:83], 0
    v_mfma_f32_16x16x32_bf16 v[24:27], v[164:167], v[84:87], v[24:27]
    s_cbranch_vccnz L_s5
    s_waitcnt vmcnt(4)
L_s5:
    s_waitcnt vmcnt(5)
    buffer_load_dwordx4 v[192:195], v1, s[16:19], s58 offen offset:2048 nt
    s_nop 4
    v_mov_b32_dpp v13, v24 quad_perm:[0,0,0,0] row_mask:0xf bank_mask:0xf
    v_add_f32_dpp v13, v25, v13 quad_perm:[1,1,1,1] row_mask:0xf bank_mask:0xf
    v_add_f32_dpp v13, v26, v13 quad_perm:[2,2,2,2] row_mask:0xf bank_mask:0xf
    v_add_f32_dpp v13, v27, v13 quad_perm:[3,3,3,3] row_mask:0xf bank_mask:0xf
    v_max3_f32 v3, v3, v12, v13
    s_cbranch_vccnz L_s6
    s_waitcnt vmcnt(4)
L_s6:
    s_waitcnt vmcnt(5)
    buffer_load_dwordx4 v[196:199], v1, s[16:19], s58 offen offset:2304 nt
    s_waitcnt lgkmcnt(0)
    v_readfirstlane_b32 s70, v223
    v_add_u32 v221, 1, v221
    s_cmp_eq_u32 s70, 1
    s_cselect_b64 vcc, -1, 0
    ds_write_b32 v222, v221
    ds_read_b32 v223, v222 offset:4
    v_mfma_f32_16x16x32_bf16 v[20:23], v[168:171], v[80:83], 0
    v_mfma_f32_16x16x32_bf16 v[20:23], v[172:175], v[84:87], v[20:23]
    s_cbranch_vccnz L_s7
    s_waitcnt vmcnt(4)
L_s7:
    s_waitcnt vmcnt(5)
    buffer_load_dwordx4 v[200:203], v1, s[16:19], s59 offen offset:0 nt
    s_nop 4
    v_mov_b32_dpp v14, v20 quad_perm:[0,0,0,0] row_mask:0xf bank_mask:0xf
    v_add_f32_dpp v14, v21, v14 quad_perm:[1,1,1,1] row_mask:0xf bank_mask:0xf
    v_add_f32_dpp v14, v22, v14 quad_perm:[2,2,2,2] row_mask:0xf bank_mask:0xf
    v_add_f32_dpp v14, v23, v14 quad_perm:[3,3,3,3] row_mask:0xf bank_mask:0xf
    s_cbranch_vccnz L_s8
    s_waitcnt vmcnt(4)
L_s8:
    s_waitcnt vmcnt(5)
    buffer_load_dwordx4 v[204:207], v1, s[16:19], s59 offen offset:256 nt
    s_waitcnt lgkmcnt(0)
    v_readfirstlane_b32 s70, v223
    v_add_u32 v221, 1, v221
    s_cmp_eq_u32 s70, 1
    s_cselect_b64 vcc, -1, 0
    ds_write_b32 v222, v221
    ds_read_b32 v223, v222 offset:4
    v_mfma_f32_16x16x32_bf16 v[24:27], v[176:179], v[80:83], 0
    v_mfma_f32_16x16x32_bf16 v[24:27], v[180:183], v[84:87], v[24:27]
    s_cbranch_vccnz L_s9
    s_waitcnt vmcnt(4)
L_s9:
    s_waitcnt vmcnt(5)
    buffer_load_dwordx4 v[208:211], v1, s[16:19], s59 offen offset:2048 nt
    s_nop 4
    v_mov_b32_dpp v15, v24 quad_perm:[0,0,0,0] row_mask:0xf bank_mask:0xf
    v_add_f32_dpp v15, v25, v15 quad_perm:[1,1,1,1] row_mask:0xf bank_mask:0xf
    v_add_f32_dpp v15, v26, v15 quad_perm:[2,2,2,2] row_mask:0xf bank_mask:0xf
    v_add_f32_dpp v15, v27, v15 quad_perm:[3,3,3,3] row_mask:0xf bank_mask:0xf
    v_max3_f32 v3, v3, v14, v15
    ds_write_b128 v216, v[12:15]
    s_cbranch_vccnz L_s10
    s_waitcnt vmcnt(4)
L_s10:
    s_waitcnt vmcnt(5)
    buffer_load_dwordx4 v[212:215], v1, s[16:19], s59 offen offset:2304 nt
    s_waitcnt lgkmcnt(0)
    v_readfirstlane_b32 s70, v223
    v_add_u32 v221, 1, v221
    s_cmp_eq_u32 s70, 1
    s_cselect_b64 vcc, -1, 0
    ds_write_b32 v222, v221
    ds_read_b32 v223, v222 offset:4
    v_mfma_f32_16x16x32_bf16 v[20:23], v[184:187], v[80:83], 0
    v_mfma_f32_16x16x32_bf16 v[20:23], v[188:191], v[84:87], v[20:23]
    s_add_u32 s56, s56, 131072
    s_add_u32 s57, s57, 131072
    s_add_u32 s58, s58, 131072
    s_add_u32 s59, s59, 131072
    s_mov_b32 s37, 1
L_kloop:
    s_cbranch_vccnz L_s11
    s_waitcnt vmcnt(4)
L_s11:
    s_waitcnt vmcnt(5)
    buffer_load_dwordx4 v[152:155], v1, s[16:19], s56 offen offset:0 nt
    v_mov_b32_dpp v16, v20 quad_perm:[0,0,0,0] row_mask:0xf bank_mask:0xf
    v_add_f32_dpp v16, v21, v16 quad_perm:[1,1,1,1] row_mask:0xf bank_mask:0xf
    v_add_f32_dpp v16, v22, v16 quad_perm:[2,2,2,2] row_mask:0xf bank_mask:0xf
    v_add_f32_dpp v16, v23, v16 quad_perm:[3,3,3,3] row_mask:0xf bank_mask:0xf
    s_cbranch_vccnz L_s12
    s_waitcnt vmcnt(4)
L_s12:
    s_waitcnt vmcnt(5)
    buffer_load_dwordx4 v[156:159], v1, s[16:19], s56 offen offset:256 nt
    s_waitcnt lgkmcnt(0)
    v_readfirstlane_b32 s70, v223
    v_add_u32 v221, 1, v221
    s_cmp_eq_u32 s70, 1
    s_cselect_b64 vcc, -1, 0
    ds_write_b32 v222, v221
    ds_read_b32 v223, v222 offset:4
    v_mfma_f32_16x16x32_bf16 v[24:27], v[192:195], v[80:83], 0
    v_mfma_f32_16x16x32_bf16 v[24:27], v[196:199], v[84:87], v[24:27]
    s_cbranch_vccnz L_s13
    s_waitcnt vmcnt(4)
L_s13:
    s_waitcnt vmcnt(5)
    buffer_load_dwordx4 v[160:163], v1, s[16:19], s56 offen offset:2048 nt
    s_nop 4
    v_mov_b32_dpp v17, v24 quad_perm:[0,0,0,0] row_mask:0xf bank_mask:0xf
    v_add_f32_dpp v17, v25, v17 quad_perm:[1,1,1,1] row_mask:0xf bank_mask:0xf
    v_add_f32_dpp v17, v26, v17 quad_perm:[2,2,2,2] row_mask:0xf bank_mask:0xf
    v_add_f32_dpp v17, v27, v17 quad_perm:[3,3,3,3] row_mask:0xf bank_mask:0xf
    v_max3_f32 v3, v3, v16, v17
    s_cbranch_vccnz L_s14
    s_waitcnt vmcnt(4)
L_s14:
    s_waitcnt vmcnt(5)
    buffer_load_dwordx4 v[164:167], v1, s[16:19], s56 offen offset:2304 nt
    s_waitcnt lgkmcnt(0)
    v_readfirstlane_b32 s70, v223
    v_add_u32 v221, 1, v221
    s_cmp_eq_u32 s70, 1
    s_cselect_b64 vcc, -1, 0
    ds_write_b32 v222, v221
    ds_read_b32 v223, v222 offset:4
    v_mfma_f32_16x16x32_bf16 v[20:23], v[200:203], v[80:83], 0
    v_mfma_f32_16x16x32_bf16 v[20:23], v[204:207], v[84:87], v[20:23]
    s_cbranch_vccnz L_s15
    s_waitcnt vmcnt(4)
L_s15:
    s_waitcnt vmcnt(5)
    buffer_load_dwordx4 v[168:171], v1, s[16:19], s57 offen offset:0 nt
    s_nop 4
    v_mov_b32_dpp v18, v20 quad_perm:[0,0,0,0] row_mask:0xf bank_mask:0xf
    v_add_f32_dpp v18, v21, v18 quad_perm:[1,1,1,1] row_mask:0xf bank_mask:0xf
    v_add_f32_dpp v18, v22, v18 quad_perm:[2,2,2,2] row_mask:0xf bank_mask:0xf
    v_add_f32_dpp v18, v23, v18 quad_perm:[3,3,3,3] row_mask:0xf bank_mask:0xf
    s_cbranch_vccnz L_s16
    s_waitcnt vmcnt(4)
L_s16:
    s_waitcnt vmcnt(5)
    buffer_load_dwordx4 v[172:175], v1, s[16:19], s57 offen offset:256 nt
    s_waitcnt lgkmcnt(0)
    v_readfirstlane_b32 s70, v223
    v_add_u32 v221, 1, v221
    s_cmp_eq_u32 s70, 1
    s_cselect_b64 vcc, -1, 0
    ds_write_b32 v222, v221
    ds_read_b32 v223, v222 offset:4
    v_mfma_f32_16x16x32_bf16 v[24:27], v[208:211], v[80:83], 0
    v_mfma_f32_16x16x32_bf16 v[24:27], v[212:215], v[84:87], v[24:27]
    s_cbranch_vccnz L_s17
    s_waitcnt vmcnt(4)
L_s17:
    s_waitcnt vmcnt(5)
    buffer_load_dwordx4 v[176:179], v1, s[16:19], s57 offen offset:2048 nt
    s_nop 4
    v_mov_b32_dpp v19, v24 quad_perm:[0,0,0,0] row_mask:0xf bank_mask:0xf
    v_add_f32_dpp v19, v25, v19 quad_perm:[1,1,1,1] row_mask:0xf bank_mask:0xf
    v_add_f32_dpp v19, v26, v19 quad_perm:[2,2,2,2] row_mask:0xf bank_mask:0xf
    v_add_f32_dpp v19, v27, v19 quad_perm:[3,3,3,3] row_mask:0xf bank_mask:0xf
    v_max3_f32 v3, v3, v18, v19
    ds_write_b128 v216, v[16:19] offset:16
    v_add_u32 v216, 512, v216
    s_cbranch_vccnz L_s18
    s_waitcnt vmcnt(4)
L_s18:
    s_waitcnt vmcnt(5)
    buffer_load_dwordx4 v[180:183], v1, s[16:19], s57 offen offset:2304 nt
    s_waitcnt lgkmcnt(0)
    v_readfirstlane_b32 s70, v223
    v_add_u32 v221, 1, v221
    s_cmp_eq_u32 s70, 1
    s_cselect_b64 vcc, -1, 0
    ds_write_b32 v222, v221
    ds_read_b32 v223, v222 offset:4
    v_mfma_f32_16x16x32_bf16 v[20:23], v[152:155], v[80:83], 0
    v_mfma_f32_16x16x32_bf16 v[20:23], v[156:159], v[84:87], v[20:23]
    s_cbranch_vccnz L_s19
    s_waitcnt vmcnt(4)
L_s19:
    s_waitcnt vmcnt(5)
    buffer_load_dwordx4 v[184:187], v1, s[16:19], s58 offen offset:0 nt
    s_nop 4
    v_mov_b32_dpp v12, v20 quad_perm:[0,0,0,0] row_mask:0xf bank_mask:0xf
    v_add_f32_dpp v12, v21, v12 quad_perm:[1,1,1,1] row_mask:0xf bank_mask:0xf
    v_add_f32_dpp v12, v22, v12 quad_perm:[2,2,2,2] row_mask:0xf bank_mask:0xf
    v_add_f32_dpp v12, v23, v12 quad_perm:[3,3,3,3] row_mask:0xf bank_mask:0xf
    s_cbranch_vccnz L_s20
    s_waitcnt vmcnt(4)
L_s20:
    s_waitcnt vmcnt(5)
    buffer_load_dwordx4 v[188:191], v1, s[16:19], s58 offen offset:256 nt
    s_waitcnt lgkmcnt(0)
    v_readfirstlane_b32 s70, v223
    v_add_u32 v221, 1, v221
    s_cmp_eq_u32 s70, 1
    s_cselect_b64 vcc, -1, 0
    ds_write_b32 v222, v221
    ds_read_b32 v223, v222 offset:4
    v_mfma_f32_16x16x32_bf16 v[24:27], v[160:163], v[80:83], 0
    v_mfma_f32_16x16x32_bf16 v[24:27], v[164:167], v[84:87], v[24:27]
    s_cbranch_vccnz L_s21
    s_waitcnt vmcnt(4)
L_s21:
    s_waitcnt vmcnt(5)
    buffer_load_dwordx4 v[192:195], v1, s[16:19], s58 offen offset:2048 nt
    s_nop 4
    v_mov_b32_dpp v13, v24 quad_perm:[0,0,0,0] row_mask:0xf bank_mask:0xf
    v_add_f32_dpp v13, v25, v13 quad_perm:[1,1,1,1] row_mask:0xf bank_mask:0xf
    v_add_f32_dpp v13, v26, v13 quad_perm:[2,2,2,2] row_mask:0xf bank_mask:0xf
    v_add_f32_dpp v13, v27, v13 quad_perm:[3,3,3,3] row_mask:0xf bank_mask:0xf
    v_max3_f32 v3, v3, v12, v13
    s_cbranch_vccnz L_s22
    s_waitcnt vmcnt(4)
L_s22:
    s_waitcnt vmcnt(5)
    buffer_load_dwordx4 v[196:199], v1, s[16:19], s58 offen offset:2304 nt
    s_waitcnt lgkmcnt(0)
    v_readfirstlane_b32 s70, v223
    v_add_u32 v221, 1, v221
    s_cmp_eq_u32 s70, 1
    s_cselect_b64 vcc, -1, 0
    ds_write_b32 v222, v221
    ds_read_b32 v223, v222 offset:4
    v_mfma_f32_16x16x32_bf16 v[20:23], v[168:171], v[80:83], 0
    v_mfma_f32_16x16x32_bf16 v[20:23], v[172:175], v[84:87], v[20:23]
    s_cbranch_vccnz L_s23
    s_waitcnt vmcnt(4)
L_s23:
    s_waitcnt vmcnt(5)
    buffer_load_dwordx4 v[200:203], v1, s[16:19], s59 offen offset:0 nt
    s_nop 4
    v_mov_b32_dpp v14, v20 quad_perm:[0,0,0,0] row_mask:0xf bank_mask:0xf
    v_add_f32_dpp v14, v21, v14 quad_perm:[1,1,1,1] row_mask:0xf bank_mask:0xf
    v_add_f32_dpp v14, v22, v14 quad_perm:[2,2,2,2] row_mask:0xf bank_mask:0xf
    v_add_f32_dpp v14, v23, v14 quad_perm:[3,3,3,3] row_mask:0xf bank_mask:0xf
    s_cbranch_vccnz L_s24
    s_waitcnt vmcnt(4)
L_s24:
    s_waitcnt vmcnt(5)
    buffer_load_dwordx4 v[204:207], v1, s[16:19], s59 offen offset:256 nt
    s_waitcnt lgkmcnt(0)
    v_readfirstlane_b32 s70, v223
    v_add_u32 v221, 1, v221
    s_cmp_eq_u32 s70, 1
    s_cselect_b64 vcc, -1, 0
    ds_write_b32 v222, v221
    ds_read_b32 v223, v222 offset:4
    v_mfma_f32_16x16x32_bf16 v[24:27], v[176:179], v[80:83], 0
    v_mfma_f32_16x16x32_bf16 v[24:27], v[180:183], v[84:87], v[24:27]
    s_cbranch_vccnz L_s25
    s_waitcnt vmcnt(4)
L_s25:
    s_waitcnt vmcnt(5)
    buffer_load_dwordx4 v[208:211], v1, s[16:19], s59 offen offset:2048 nt
    s_nop 4
    v_mov_b32_dpp v15, v24 quad_perm:[0,0,0,0] row_mask:0xf bank_mask:0xf
    v_add_f32_dpp v15, v25, v15 quad_perm:[1,1,1,1] row_mask:0xf bank_mask:0xf
    v_add_f32_dpp v15, v26, v15 quad_perm:[2,2,2,2] row_mask:0xf bank_mask:0xf
    v_add_f32_dpp v15, v27, v15 quad_perm:[3,3,3,3] row_mask:0xf bank_mask:0xf
    v_max3_f32 v3, v3, v14, v15
    ds_write_b128 v216, v[12:15]
    s_cbranch_vccnz L_s26
    s_waitcnt vmcnt(4)
L_s26:
    s_waitcnt vmcnt(5)
    buffer_load_dwordx4 v[212:215], v1, s[16:19], s59 offen offset:2304 nt
    s_waitcnt lgkmcnt(0)
    v_readfirstlane_b32 s70, v223
    v_add_u32 v221, 1, v221
    s_cmp_eq_u32 s70, 1
    s_cselect_b64 vcc, -1, 0
    ds_write_b32 v222, v221
    ds_read_b32 v223, v222 offset:4
    v_mfma_f32_16x16x32_bf16 v[20:23], v[184:187], v[80:83], 0
    v_mfma_f32_16x16x32_bf16 v[20:23], v[188:191], v[84:87], v[20:23]
    s_add_u32 s56, s56, 131072
    s_add_u32 s57, s57, 131072
    s_add_u32 s58, s58, 131072
    s_add_u32 s59, s59, 131072
    s_add_u32 s37, s37, 1
    s_cmp_lt_u32 s37, 16
    s_cbranch_scc1 L_kloop
    s_add_u32 s56, s68, 0
    s_add_u32 s57, s68, 32768
    s_add_u32 s58, s68, 65536
    s_add_u32 s59, s68, 98304
    s_cbranch_vccnz L_s27
    s_waitcnt vmcnt(4)
L_s27:
    s_waitcnt vmcnt(5)
    buffer_load_dwordx4 v[88:91], v2, s[20:23], s56 offen offset:0 nt
    v_mov_b32_dpp v16, v20 quad_perm:[0,0,0,0] row_mask:0xf bank_mask:0xf
    v_add_f32_dpp v16, v21, v16 quad_perm:[1,1,1,1] row_mask:0xf bank_mask:0xf
    v_add_f32_dpp v16, v22, v16 quad_perm:[2,2,2,2] row_mask:0xf bank_mask:0xf
    v_add_f32_dpp v16, v23, v16 quad_perm:[3,3,3,3] row_mask:0xf bank_mask:0xf
    s_cbranch_vccnz L_s28
    s_waitcnt vmcnt(4)
L_s28:
    s_waitcnt vmcnt(5)
    buffer_load_dwordx4 v[92:95], v2, s[20:23], s56 offen offset:256 nt
    s_waitcnt lgkmcnt(0)
    v_readfirstlane_b32 s70, v223
    v_add_u32 v221, 1, v221
    s_cmp_eq_u32 s70, 1
    s_cselect_b64 vcc, -1, 0
    ds_write_b32 v222, v221
    ds_read_b32 v223, v222 offset:4
    v_mfma_f32_16x16x32_bf16 v[24:27], v[192:195], v[80:83], 0
    v_mfma_f32_16x16x32_bf16 v[24:27], v[196:199], v[84:87], v[24:27]
    s_cbranch_vccnz L_s29
    s_waitcnt vmcnt(4)
L_s29:
    s_waitcnt vmcnt(5)
    buffer_load_dwordx4 v[96:99], v2, s[20:23], s56 offen offset:2048 nt
    s_nop 4
    v_mov_b32_dpp v17, v24 quad_perm:[0,0,0,0] row_mask:0xf bank_mask:0xf
    v_add_f32_dpp v17, v25, v17 quad_perm:[1,1,1,1] row_mask:0xf bank_mask:0xf
    v_add_f32_dpp v17, v26, v17 quad_perm:[2,2,2,2] row_mask:0xf bank_mask:0xf
    v_add_f32_dpp v17, v27, v17 quad_perm:[3,3,3,3] row_mask:0xf bank_mask:0xf
    v_max3_f32 v3, v3, v16, v17
    s_cbranch_vccnz L_s30
    s_waitcnt vmcnt(4)
L_s30:
    s_waitcnt vmcnt(5)
    buffer_load_dwordx4 v[100:103], v2, s[20:23], s56 offen offset:2304 nt
    s_waitcnt lgkmcnt(0)
    v_readfirstlane_b32 s70, v223
    v_add_u32 v221, 1, v221
    s_cmp_eq_u32 s70, 1
    s_cselect_b64 vcc, -1, 0
    ds_write_b32 v222, v221
    ds_read_b32 v223, v222 offset:4
    v_mfma_f32_16x16x32_bf16 v[20:23], v[200:203], v[80:83], 0
    v_mfma_f32_16x16x32_bf16 v[20:23], v[204:207], v[84:87], v[20:23]
    s_cbranch_vccnz L_s31
    s_waitcnt vmcnt(4)
L_s31:
    s_waitcnt vmcnt(5)
    buffer_load_dwordx4 v[104:107], v2, s[20:23], s57 offen offset:0 nt
    s_nop 4
    v_mov_b32_dpp v18, v20 quad_perm:[0,0,0,0] row_mask:0xf bank_mask:0xf
    v_add_f32_dpp v18, v21, v18 quad_perm:[1,1,1,1] row_mask:0xf bank_mask:0xf
    v_add_f32_dpp v18, v22, v18 quad_perm:[2,2,2,2] row_mask:0xf bank_mask:0xf
    v_add_f32_dpp v18, v23, v18 quad_perm:[3,3,3,3] row_mask:0xf bank_mask:0xf
    s_cbranch_vccnz L_s32
    s_waitcnt vmcnt(4)
L_s32:
    s_waitcnt vmcnt(5)
    buffer_load_dwordx4 v[108:111], v2, s[20:23], s57 offen offset:256 nt
    s_waitcnt lgkmcnt(0)
    v_readfirstlane_b32 s70, v223
    v_add_u32 v221, 1, v221
    s_cmp_eq_u32 s70, 1
    s_cselect_b64 vcc, -1, 0
    ds_write_b32 v222, v221
    ds_read_b32 v223, v222 offset:4
    v_mfma_f32_16x16x32_bf16 v[24:27], v[208:211], v[80:83], 0
    v_mfma_f32_16x16x32_bf16 v[24:27], v[212:215], v[84:87], v[24:27]
    s_cbranch_vccnz L_s33
    s_waitcnt vmcnt(4)
L_s33:
    s_waitcnt vmcnt(5)
    buffer_load_dwordx4 v[112:115], v2, s[20:23], s57 offen offset:2048 nt
    s_nop 4
    v_mov_b32_dpp v19, v24 quad_perm:[0,0,0,0] row_mask:0xf bank_mask:0xf
    v_add_f32_dpp v19, v25, v19 quad_perm:[1,1,1,1] row_mask:0xf bank_mask:0xf
    v_add_f32_dpp v19, v26, v19 quad_perm:[2,2,2,2] row_mask:0xf bank_mask:0xf
    v_add_f32_dpp v19, v27, v19 quad_perm:[3,3,3,3] row_mask:0xf bank_mask:0xf
    v_max3_f32 v3, v3, v18, v19
    ds_write_b128 v216, v[16:19] offset:16
    v_add_u32 v216, 512, v216
    s_cbranch_vccnz L_s34
    s_waitcnt vmcnt(4)
L_s34:
    s_waitcnt vmcnt(5)
    buffer_load_dwordx4 v[116:119], v2, s[20:23], s57 offen offset:2304 nt
    s_waitcnt lgkmcnt(0)
    v_readfirstlane_b32 s70, v223
    v_add_u32 v221, 1, v221
    s_cmp_eq_u32 s70, 1
    s_cselect_b64 vcc, -1, 0
    ds_write_b32 v222, v221
    ds_read_b32 v223, v222 offset:4
    ds_read_b128 v[12:15], v217
    ds_read_b128 v[16:19], v217 offset:16
    v_add_u32 v217, 512, v217
    v_mov_b32 v5, v3
    s_nop 1
    v_permlane32_swap_b32 v3, v5
    v_max_f32 v3, v3, v5
    v_mov_b32 v5, v3
    s_nop 1
    v_permlane16_swap_b32 v3, v5
    v_max_f32 v3, v3, v5
    ds_write_b32 v219, v3 offset:64
    v_mul_f32 v218, s38, v3
    s_cbranch_vccnz L_s35
    s_waitcnt vmcnt(4)
L_s35:
    s_waitcnt vmcnt(5)
    buffer_load_dwordx4 v[120:123], v2, s[20:23], s58 offen offset:0 nt
    s_waitcnt lgkmcnt(0)
    v_fma_f32 v12, v12, s38, -v218
    v_fma_f32 v13, v13, s38, -v218
    v_fma_f32 v14, v14, s38, -v218
    s_cbranch_vccnz L_s36
    s_waitcnt vmcnt(4)
L_s36:
    s_waitcnt vmcnt(5)
    buffer_load_dwordx4 v[124:127], v2, s[20:23], s58 offen offset:256 nt
    s_waitcnt lgkmcnt(0)
    v_readfirstlane_b32 s70, v223
    v_add_u32 v221, 1, v221
    s_cmp_eq_u32 s70, 1
    s_cselect_b64 vcc, -1, 0
    ds_write_b32 v222, v221
    ds_read_b32 v223, v222 offset:4
    v_fma_f32 v15, v15, s38, -v218
    v_fma_f32 v16, v16, s38, -v218
    v_fma_f32 v17, v17, s38, -v218
    v_fma_f32 v18, v18, s38, -v218
    s_cbranch_vccnz L_s37
    s_waitcnt vmcnt(4)
L_s37:
    s_waitcnt vmcnt(5)
    buffer_load_dwordx4 v[128:131], v2, s[20:23], s58 offen offset:2048 nt
    v_fma_f32 v19, v19, s38, -v218
    v_exp_f32 v12, v12
    v_exp_f32 v13, v13
    s_cbranch_vccnz L_s38
    s_waitcnt vmcnt(4)
L_s38:
    s_waitcnt vmcnt(5)
    buffer_load_dwordx4 v[132:135], v2, s[20:23], s58 offen offset:2304 nt
    s_waitcnt lgkmcnt(0)
    v_readfirstlane_b32 s70, v223
    v_add_u32 v221, 1, v221
    s_cmp_eq_u32 s70, 1
    s_cselect_b64 vcc, -1, 0
    ds_write_b32 v222, v221
    ds_read_b32 v223, v222 offset:4
    v_exp_f32 v14, v14
    v_exp_f32 v15, v15
    v_exp_f32 v16, v16
    v_exp_f32 v17, v17
    s_cbranch_vccnz L_s39
    s_waitcnt vmcnt(4)
L_s39:
    s_waitcnt vmcnt(5)
    buffer_load_dwordx4 v[136:139], v2, s[20:23], s59 offen offset:0 nt
    v_exp_f32 v18, v18
    v_exp_f32 v19, v19
    v_add_f32 v8, v12, v13
    v_add_f32 v9, v14, v15
    s_cbranch_vccnz L_s40
    s_waitcnt vmcnt(4)
L_s40:
    s_waitcnt vmcnt(5)
    buffer_load_dwordx4 v[140:143], v2, s[20:23], s59 offen offset:256 nt
    s_waitcnt lgkmcnt(0)
    v_readfirstlane_b32 s70, v223
    v_add_u32 v221, 1, v221
    s_cmp_eq_u32 s70, 1
    s_cselect_b64 vcc, -1, 0
    ds_write_b32 v222, v221
    ds_read_b32 v223, v222 offset:4
    v_add_f32 v10, v16, v17
    v_add_f32 v11, v18, v19
    v_cvt_pk_bf16_f32 v28, v12, v13
    s_cbranch_vccnz L_s41
    s_waitcnt vmcnt(4)
L_s41:
    s_waitcnt vmcnt(5)
    buffer_load_dwordx4 v[144:147], v2, s[20:23], s59 offen offset:2048 nt
    v_cvt_pk_bf16_f32 v29, v14, v15
    v_cvt_pk_bf16_f32 v30, v16, v17
    v_cvt_pk_bf16_f32 v31, v18, v19
    v_add_f32 v8, v8, v9
    s_cbranch_vccnz L_s42
    s_waitcnt vmcnt(4)
L_s42:
    s_waitcnt vmcnt(5)
    buffer_load_dwordx4 v[148:151], v2, s[20:23], s59 offen offset:2304 nt
    s_waitcnt lgkmcnt(0)
    v_readfirstlane_b32 s70, v223
    v_add_u32 v221, 1, v221
    s_cmp_eq_u32 s70, 1
    s_cselect_b64 vcc, -1, 0
    ds_write_b32 v222, v221
    ds_read_b32 v223, v222 offset:4
    v_add_f32 v10, v10, v11
    v_add_f32 v8, v8, v10
    v_add_f32 v4, v4, v8
    s_add_u32 s56, s56, 131072
    s_add_u32 s57, s57, 131072
    s_add_u32 s58, s58, 131072
    s_add_u32 s59, s59, 131072
    s_mov_b32 s37, 0
L_vloop:
    s_cbranch_vccnz L_s43
    s_waitcnt vmcnt(4)
L_s43:
    s_waitcnt vmcnt(5)
    buffer_load_dwordx4 v[152:155], v2, s[20:23], s56 offen offset:0 nt
    ds_read_b128 v[12:15], v217
    ds_read_b128 v[16:19], v217 offset:16
    v_add_u32 v217, 512, v217
    v_cndmask_b32_e64 v32, 0, v28, s[60:61]
    v_cndmask_b32_e64 v33, 0, v29, s[60:61]
    v_cndmask_b32_e64 v34, 0, v30, s[60:61]
    v_cndmask_b32_e64 v35, 0, v31, s[60:61]
    s_cbranch_vccnz L_s44
    s_waitcnt vmcnt(4)
L_s44:
    s_waitcnt vmcnt(5)
    buffer_load_dwordx4 v[156:159], v2, s[20:23], s56 offen offset:256 nt
    s_waitcnt lgkmcnt(0)
    v_readfirstlane_b32 s70, v223
    v_add_u32 v221, 1, v221
    s_cmp_eq_u32 s70, 1
    s_cselect_b64 vcc, -1, 0
    ds_write_b32 v222, v221
    ds_read_b32 v223, v222 offset:4
    v_cndmask_b32_e64 v36, 0, v28, s[62:63]
    v_cndmask_b32_e64 v37, 0, v29, s[62:63]
    v_cndmask_b32_e64 v38, 0, v30, s[62:63]
    s_cbranch_vccnz L_s45
    s_waitcnt vmcnt(4)
L_s45:
    s_waitcnt vmcnt(5)
    buffer_load_dwordx4 v[160:163], v2, s[20:23], s56 offen offset:2048 nt
    v_cndmask_b32_e64 v39, 0, v31, s[62:63]
    v_cndmask_b32_e64 v40, 0, v28, s[64:65]
    v_cndmask_b32_e64 v41, 0, v29, s[64:65]
    s_cbranch_vccnz L_s46
    s_waitcnt vmcnt(4)
L_s46:
    s_waitcnt vmcnt(5)
    buffer_load_dwordx4 v[164:167], v2, s[20:23], s56 offen offset:2304 nt
    s_waitcnt lgkmcnt(0)
    v_readfirstlane_b32 s70, v223
    v_add_u32 v221, 1, v221
    s_cmp_eq_u32 s70, 1
    s_cselect_b64 vcc, -1, 0
    ds_write_b32 v222, v221
    ds_read_b32 v223, v222 offset:4
    v_cndmask_b32_e64 v42, 0, v30, s[64:65]
    v_cndmask_b32_e64 v43, 0, v31, s[64:65]
    v_cndmask_b32_e64 v44, 0, v28, s[66:67]
    s_cbranch_vccnz L_s47
    s_waitcnt vmcnt(4)
L_s47:
    s_waitcnt vmcnt(5)
    buffer_load_dwordx4 v[168:171], v2, s[20:23], s57 offen offset:0 nt
    v_cndmask_b32_e64 v45, 0, v29, s[66:67]
    v_cndmask_b32_e64 v46, 0, v30, s[66:67]
    v_cndmask_b32_e64 v47, 0, v31, s[66:67]
    s_cbranch_vccnz L_s48
    s_waitcnt vmcnt(4)
L_s48:
    s_waitcnt vmcnt(5)
    buffer_load_dwordx4 v[172:175], v2, s[20:23], s57 offen offset:256 nt
    s_waitcnt lgkmcnt(0)
    v_readfirstlane_b32 s70, v223
    v_add_u32 v221, 1, v221
    s_cmp_eq_u32 s70, 1
    s_cselect_b64 vcc, -1, 0
    ds_write_b32 v222, v221
    ds_read_b32 v223, v222 offset:4
    v_perm_b32 v48, v96, v88, s39
    v_perm_b32 v49, v112, v104, s39
    v_perm_b32 v50, v128, v120, s39
    v_perm_b32 v51, v144, v136, s39
    v_perm_b32 v52, v96, v88, s40
    v_perm_b32 v53, v112, v104, s40
    v_perm_b32 v54, v128, v120, s40
    v_perm_b32 v55, v144, v136, s40
    v_mfma_f32_16x16x32_bf16 v[64:67], v[48:51], v[32:35], v[64:67]
    s_waitcnt lgkmcnt(0)
    v_fma_f32 v12, v12, s38, -v218
    v_fma_f32 v13, v13, s38, -v218
    s_cbranch_vccnz L_s49
    s_waitcnt vmcnt(4)
L_s49:
    s_waitcnt vmcnt(5)
    buffer_load_dwordx4 v[176:179], v2, s[20:23], s57 offen offset:2048 nt
    v_perm_b32 v56, v97, v89, s39
    v_perm_b32 v57, v113, v105, s39
    v_perm_b32 v58, v129, v121, s39
    v_perm_b32 v59, v145, v137, s39
    v_mfma_f32_16x16x32_bf16 v[64:67], v[52:55], v[36:39], v[64:67]
    v_perm_b32 v60, v97, v89, s40
    v_perm_b32 v61, v113, v105, s40
    v_perm_b32 v62, v129, v121, s40
    v_perm_b32 v63, v145, v137, s40
    v_mfma_f32_16x16x32_bf16 v[64:67], v[56:59], v[40:43], v[64:67]
    v_fma_f32 v14, v14, s38, -v218
    v_fma_f32 v15, v15, s38, -v218
    v_fma_f32 v16, v16, s38, -v218
    s_cbranch_vccnz L_s50
    s_waitcnt vmcnt(4)
L_s50:
    s_waitcnt vmcnt(5)
    buffer_load_dwordx4 v[180:183], v2, s[20:23], s57 offen offset:2304 nt
    s_waitcnt lgkmcnt(0)
    v_readfirstlane_b32 s70, v223
    v_add_u32 v221, 1, v221
    s_cmp_eq_u32 s70, 1
    s_cselect_b64 vcc, -1, 0
    ds_write_b32 v222, v221
    ds_read_b32 v223, v222 offset:4
    v_perm_b32 v48, v98, v90, s39
    v_perm_b32 v49, v114, v106, s39
    v_perm_b32 v50, v130, v122, s39
    v_perm_b32 v51, v146, v138, s39
    v_mfma_f32_16x16x32_bf16 v[64:67], v[60:63], v[44:47], v[64:67]
    v_fma_f32 v17, v17, s38, -v218
    v_fma_f32 v18, v18, s38, -v218
    s_cbranch_vccnz L_s51
    s_waitcnt vmcnt(4)
L_s51:
    s_waitcnt vmcnt(5)
    buffer_load_dwordx4 v[184:187], v2, s[20:23], s58 offen offset:0 nt
    v_perm_b32 v52, v98, v90, s40
    v_perm_b32 v53, v114, v106, s40
    v_perm_b32 v54, v130, v122, s40
    v_perm_b32 v55, v146, v138, s40
    v_mfma_f32_16x16x32_bf16 v[68:71], v[48:51], v[32:35], v[68:71]
    v_perm_b32 v56, v99, v91, s39
    v_perm_b32 v57, v115, v107, s39
    v_perm_b32 v58, v131, v123, s39
    v_perm_b32 v59, v147, v139, s39
    v_mfma_f32_16x16x32_bf16 v[68:71], v[52:55], v[36:39], v[68:71]
    v_fma_f32 v19, v19, s38, -v218
    v_exp_f32 v12, v12
    v_exp_f32 v13, v13
    s_cbranch_vccnz L_s52
    s_waitcnt vmcnt(4)
L_s52:
    s_waitcnt vmcnt(5)
    buffer_load_dwordx4 v[188:191], v2, s[20:23], s58 offen offset:256 nt
    s_waitcnt lgkmcnt(0)
    v_readfirstlane_b32 s70, v223
    v_add_u32 v221, 1, v221
    s_cmp_eq_u32 s70, 1
    s_cselect_b64 vcc, -1, 0
    ds_write_b32 v222, v221
    ds_read_b32 v223, v222 offset:4
    v_perm_b32 v60, v99, v91, s40
    v_perm_b32 v61, v115, v107, s40
    v_perm_b32 v62, v131, v123, s40
    v_perm_b32 v63, v147, v139, s40
    v_mfma_f32_16x16x32_bf16 v[68:71], v[56:59], v[40:43], v[68:71]
    v_exp_f32 v14, v14
    v_exp_f32 v15, v15
    v_exp_f32 v16, v16
    s_cbranch_vccnz L_s53
    s_waitcnt vmcnt(4)
L_s53:
    s_waitcnt vmcnt(5)
    buffer_load_dwordx4 v[192:195], v2, s[20:23], s58 offen offset:2048 nt
    v_perm_b32 v48, v100, v92, s39
    v_perm_b32 v49, v116, v108, s39
    v_perm_b32 v50, v132, v124, s39
    v_perm_b32 v51, v148, v140, s39
    v_mfma_f32_16x16x32_bf16 v[68:71], v[60:63], v[44:47], v[68:71]
    v_perm_b32 v52, v100, v92, s40
    v_perm_b32 v53, v116, v108, s40
    v_perm_b32 v54, v132, v124, s40
    v_perm_b32 v55, v148, v140, s40
    v_mfma_f32_16x16x32_bf16 v[72:75], v[48:51], v[32:35], v[72:75]
    v_exp_f32 v17, v17
    v_exp_f32 v18, v18
    s_cbranch_vccnz L_s54
    s_waitcnt vmcnt(4)
L_s54:
    s_waitcnt vmcnt(5)
    buffer_load_dwordx4 v[196:199], v2, s[20:23], s58 offen offset:2304 nt
    s_waitcnt lgkmcnt(0)
    v_readfirstlane_b32 s70, v223
    v_add_u32 v221, 1, v221
    s_cmp_eq_u32 s70, 1
    s_cselect_b64 vcc, -1, 0
    ds_write_b32 v222, v221
    ds_read_b32 v223, v222 offset:4
    v_perm_b32 v56, v101, v93, s39
    v_perm_b32 v57, v117, v109, s39
    v_perm_b32 v58, v133, v125, s39
    v_perm_b32 v59, v149, v141, s39
    v_mfma_f32_16x16x32_bf16 v[72:75], v[52:55], v[36:39], v[72:75]
    v_exp_f32 v19, v19
    v_add_f32 v8, v12, v13
    v_add_f32 v9, v14, v15
    s_cbranch_vccnz L_s55
    s_waitcnt vmcnt(4)
L_s55:
    s_waitcnt vmcnt(5)
    buffer_load_dwordx4 v[200:203], v2, s[20:23], s59 offen offset:0 nt
    v_perm_b32 v60, v101, v93, s40
    v_perm_b32 v61, v117, v109, s40
    v_perm_b32 v62, v133, v125, s40
    v_perm_b32 v63, v149, v141, s40
    v_mfma_f32_16x16x32_bf16 v[72:75], v[56:59], v[40:43], v[72:75]
    v_perm_b32 v48, v102, v94, s39
    v_perm_b32 v49, v118, v110, s39
    v_perm_b32 v50, v134, v126, s39
    v_perm_b32 v51, v150, v142, s39
    v_mfma_f32_16x16x32_bf16 v[72:75], v[60:63], v[44:47], v[72:75]
    v_add_f32 v10, v16, v17
    v_add_f32 v11, v18, v19
    v_cvt_pk_bf16_f32 v28, v12, v13
    s_cbranch_vccnz L_s56
    s_waitcnt vmcnt(4)
L_s56:
    s_waitcnt vmcnt(5)
    buffer_load_dwordx4 v[204:207], v2, s[20:23], s59 offen offset:256 nt
    s_waitcnt lgkmcnt(0)
    v_readfirstlane_b32 s70, v223
    v_add_u32 v221, 1, v221
    s_cmp_eq_u32 s70, 1
    s_cselect_b64 vcc, -1, 0
    ds_write_b32 v222, v221
    ds_read_b32 v223, v222 offset:4
    v_perm_b32 v52, v102, v94, s40
    v_perm_b32 v53, v118, v110, s40
    v_perm_b32 v54, v134, v126, s40
    v_perm_b32 v55, v150, v142, s40
    v_mfma_f32_16x16x32_bf16 v[76:79], v[48:51], v[32:35], v[76:79]
    v_cvt_pk_bf16_f32 v29, v14, v15
    v_cvt_pk_bf16_f32 v30, v16, v17
    s_cbranch_vccnz L_s57
    s_waitcnt vmcnt(4)
L_s57:
    s_waitcnt vmcnt(5)
    buffer_load_dwordx4 v[208:211], v2, s[20:23], s59 offen offset:2048 nt
    v_perm_b32 v56, v103, v95, s39
    v_perm_b32 v57, v119, v111, s39
    v_perm_b32 v58, v135, v127, s39
    v_perm_b32 v59, v151, v143, s39
    v_mfma_f32_16x16x32_bf16 v[76:79], v[52:55], v[36:39], v[76:79]
    v_perm_b32 v60, v103, v95, s40
    v_perm_b32 v61, v119, v111, s40
    v_perm_b32 v62, v135, v127, s40
    v_perm_b32 v63, v151, v143, s40
    v_mfma_f32_16x16x32_bf16 v[76:79], v[56:59], v[40:43], v[76:79]
    v_cvt_pk_bf16_f32 v31, v18, v19
    v_add_f32 v8, v8, v9
    v_add_f32 v10, v10, v11
    s_cbranch_vccnz L_s58
    s_waitcnt vmcnt(4)
L_s58:
    s_waitcnt vmcnt(5)
    buffer_load_dwordx4 v[212:215], v2, s[20:23], s59 offen offset:2304 nt
    s_waitcnt lgkmcnt(0)
    v_readfirstlane_b32 s70, v223
    v_add_u32 v221, 1, v221
    s_cmp_eq_u32 s70, 1
    s_cselect_b64 vcc, -1, 0
    ds_write_b32 v222, v221
    ds_read_b32 v223, v222 offset:4
    v_mfma_f32_16x16x32_bf16 v[76:79], v[60:63], v[44:47], v[76:79]
    v_add_f32 v8, v8, v10
    v_add_f32 v4, v4, v8
    s_add_u32 s56, s56, 131072
    s_add_u32 s57, s57, 131072
    s_add_u32 s58, s58, 131072
    s_add_u32 s59, s59, 131072
    s_cbranch_vccnz L_s59
    s_waitcnt vmcnt(4)
L_s59:
    s_waitcnt vmcnt(5)
    buffer_load_dwordx4 v[88:91], v2, s[20:23], s56 offen offset:0 nt
    ds_read_b128 v[12:15], v217
    ds_read_b128 v[16:19], v217 offset:16
    v_add_u32 v217, 512, v217
    v_cndmask_b32_e64 v32, 0, v28, s[60:61]
    v_cndmask_b32_e64 v33, 0, v29, s[60:61]
    v_cndmask_b32_e64 v34, 0, v30, s[60:61]
    v_cndmask_b32_e64 v35, 0, v31, s[60:61]
    s_cbranch_vccnz L_s60
    s_waitcnt vmcnt(4)
L_s60:
    s_waitcnt vmcnt(5)
    buffer_load_dwordx4 v[92:95], v2, s[20:23], s56 offen offset:256 nt
    s_waitcnt lgkmcnt(0)
    v_readfirstlane_b32 s70, v223
    v_add_u32 v221, 1, v221
    s_cmp_eq_u32 s70, 1
    s_cselect_b64 vcc, -1, 0
    ds_write_b32 v222, v221
    ds_read_b32 v223, v222 offset:4
    v_cndmask_b32_e64 v36, 0, v28, s[62:63]
    v_cndmask_b32_e64 v37, 0, v29, s[62:63]
    v_cndmask_b32_e64 v38, 0, v30, s[62:63]
    s_cbranch_vccnz L_s61
    s_waitcnt vmcnt(4)
L_s61:
    s_waitcnt vmcnt(5)
    buffer_load_dwordx4 v[96:99], v2, s[20:23], s56 offen offset:2048 nt
    v_cndmask_b32_e64 v39, 0, v31, s[62:63]
    v_cndmask_b32_e64 v40, 0, v28, s[64:65]
    v_cndmask_b32_e64 v41, 0, v29, s[64:65]
    s_cbranch_vccnz L_s62
    s_waitcnt vmcnt(4)
L_s62:
    s_waitcnt vmcnt(5)
    buffer_load_dwordx4 v[100:103], v2, s[20:23], s56 offen offset:2304 nt
    s_waitcnt lgkmcnt(0)
    v_readfirstlane_b32 s70, v223
    v_add_u32 v221, 1, v221
    s_cmp_eq_u32 s70, 1
    s_cselect_b64 vcc, -1, 0
    ds_write_b32 v222, v221
    ds_read_b32 v223, v222 offset:4
    v_cndmask_b32_e64 v42, 0, v30, s[64:65]
    v_cndmask_b32_e64 v43, 0, v31, s[64:65]
    v_cndmask_b32_e64 v44, 0, v28, s[66:67]
    s_cbranch_vccnz L_s63
    s_waitcnt vmcnt(4)
L_s63:
    s_waitcnt vmcnt(5)
    buffer_load_dwordx4 v[104:107], v2, s[20:23], s57 offen offset:0 nt
    v_cndmask_b32_e64 v45, 0, v29, s[66:67]
    v_cndmask_b32_e64 v46, 0, v30, s[66:67]
    v_cndmask_b32_e64 v47, 0, v31, s[66:67]
    s_cbranch_vccnz L_s64
    s_waitcnt vmcnt(4)
L_s64:
    s_waitcnt vmcnt(5)
    buffer_load_dwordx4 v[108:111], v2, s[20:23], s57 offen offset:256 nt
    s_waitcnt lgkmcnt(0)
    v_readfirstlane_b32 s70, v223
    v_add_u32 v221, 1, v221
    s_cmp_eq_u32 s70, 1
    s_cselect_b64 vcc, -1, 0
    ds_write_b32 v222, v221
    ds_read_b32 v223, v222 offset:4
    v_perm_b32 v48, v160, v152, s39
    v_perm_b32 v49, v176, v168, s39
    v_perm_b32 v50, v192, v184, s39
    v_perm_b32 v51, v208, v200, s39
    v_perm_b32 v52, v160, v152, s40
    v_perm_b32 v53, v176, v168, s40
    v_perm_b32 v54, v192, v184, s40
    v_perm_b32 v55, v208, v200, s40
    v_mfma_f32_16x16x32_bf16 v[64:67], v[48:51], v[32:35], v[64:67]
    s_waitcnt lgkmcnt(0)
    v_fma_f32 v12, v12, s38, -v218
    v_fma_f32 v13, v13, s38, -v218
    s_cbranch_vccnz L_s65
    s_waitcnt vmcnt(4)
L_s65:
    s_waitcnt vmcnt(5)
    buffer_load_dwordx4 v[112:115], v2, s[20:23], s57 offen offset:2048 nt
    v_perm_b32 v56, v161, v153, s39
    v_perm_b32 v57, v177, v169, s39
    v_perm_b32 v58, v193, v185, s39
    v_perm_b32 v59, v209, v201, s39
    v_mfma_f32_16x16x32_bf16 v[64:67], v[52:55], v[36:39], v[64:67]
    v_perm_b32 v60, v161, v153, s40
    v_perm_b32 v61, v177, v169, s40
    v_perm_b32 v62, v193, v185, s40
    v_perm_b32 v63, v209, v201, s40
    v_mfma_f32_16x16x32_bf16 v[64:67], v[56:59], v[40:43], v[64:67]
    v_fma_f32 v14, v14, s38, -v218
    v_fma_f32 v15, v15, s38, -v218
    v_fma_f32 v16, v16, s38, -v218
    s_cbranch_vccnz L_s66
    s_waitcnt vmcnt(4)
L_s66:
    s_waitcnt vmcnt(5)
    buffer_load_dwordx4 v[116:119], v2, s[20:23], s57 offen offset:2304 nt
    s_waitcnt lgkmcnt(0)
    v_readfirstlane_b32 s70, v223
    v_add_u32 v221, 1, v221
    s_cmp_eq_u32 s70, 1
    s_cselect_b64 vcc, -1, 0
    ds_write_b32 v222, v221
    ds_read_b32 v223, v222 offset:4
    v_perm_b32 v48, v162, v154, s39
    v_perm_b32 v49, v178, v170, s39
    v_perm_b32 v50, v194, v186, s39
    v_perm_b32 v51, v210, v202, s39
    v_mfma_f32_16x16x32_bf16 v[64:67], v[60:63], v[44:47], v[64:67]
    v_fma_f32 v17, v17, s38, -v218
    v_fma_f32 v18, v18, s38, -v218
    s_cbranch_vccnz L_s67
    s_waitcnt vmcnt(4)
L_s67:
    s_waitcnt vmcnt(5)
    buffer_load_dwordx4 v[120:123], v2, s[20:23], s58 offen offset:0 nt
    v_perm_b32 v52, v162, v154, s40
    v_perm_b32 v53, v178, v170, s40
    v_perm_b32 v54, v194, v186, s40
    v_perm_b32 v55, v210, v202, s40
    v_mfma_f32_16x16x32_bf16 v[68:71], v[48:51], v[32:35], v[68:71]
    v_perm_b32 v56, v163, v155, s39
    v_perm_b32 v57, v179, v171, s39
    v_perm_b32 v58, v195, v187, s39
    v_perm_b32 v59, v211, v203, s39
    v_mfma_f32_16x16x32_bf16 v[68:71], v[52:55], v[36:39], v[68:71]
    v_fma_f32 v19, v19, s38, -v218
    v_exp_f32 v12, v12
    v_exp_f32 v13, v13
    s_cbranch_vccnz L_s68
    s_waitcnt vmcnt(4)
L_s68:
    s_waitcnt vmcnt(5)
    buffer_load_dwordx4 v[124:127], v2, s[20:23], s58 offen offset:256 nt
    s_waitcnt lgkmcnt(0)
    v_readfirstlane_b32 s70, v223
    v_add_u32 v221, 1, v221
    s_cmp_eq_u32 s70, 1
    s_cselect_b64 vcc, -1, 0
    ds_write_b32 v222, v221
    ds_read_b32 v223, v222 offset:4
    v_perm_b32 v60, v163, v155, s40
    v_perm_b32 v61, v179, v171, s40
    v_perm_b32 v62, v195, v187, s40
    v_perm_b32 v63, v211, v203, s40
    v_mfma_f32_16x16x32_bf16 v[68:71], v[56:59], v[40:43], v[68:71]
    v_exp_f32 v14, v14
    v_exp_f32 v15, v15
    v_exp_f32 v16, v16
    s_cbranch_vccnz L_s69
    s_waitcnt vmcnt(4)
L_s69:
    s_waitcnt vmcnt(5)
    buffer_load_dwordx4 v[128:131], v2, s[20:23], s58 offen offset:2048 nt
    v_perm_b32 v48, v164, v156, s39
    v_perm_b32 v49, v180, v172, s39
    v_perm_b32 v50, v196, v188, s39
    v_perm_b32 v51, v212, v204, s39
    v_mfma_f32_16x16x32_bf16 v[68:71], v[60:63], v[44:47], v[68:71]
    v_perm_b32 v52, v164, v156, s40
    v_perm_b32 v53, v180, v172, s40
    v_perm_b32 v54, v196, v188, s40
    v_perm_b32 v55, v212, v204, s40
    v_mfma_f32_16x16x32_bf16 v[72:75], v[48:51], v[32:35], v[72:75]
    v_exp_f32 v17, v17
    v_exp_f32 v18, v18
    s_cbranch_vccnz L_s70
    s_waitcnt vmcnt(4)
L_s70:
    s_waitcnt vmcnt(5)
    buffer_load_dwordx4 v[132:135], v2, s[20:23], s58 offen offset:2304 nt
    s_waitcnt lgkmcnt(0)
    v_readfirstlane_b32 s70, v223
    v_add_u32 v221, 1, v221
    s_cmp_eq_u32 s70, 1
    s_cselect_b64 vcc, -1, 0
    ds_write_b32 v222, v221
    ds_read_b32 v223, v222 offset:4
    v_perm_b32 v56, v165, v157, s39
    v_perm_b32 v57, v181, v173, s39
    v_perm_b32 v58, v197, v189, s39
    v_perm_b32 v59, v213, v205, s39
    v_mfma_f32_16x16x32_bf16 v[72:75], v[52:55], v[36:39], v[72:75]
    v_exp_f32 v19, v19
    v_add_f32 v8, v12, v13
    v_add_f32 v9, v14, v15
    s_cbranch_vccnz L_s71
    s_waitcnt vmcnt(4)
L_s71:
    s_waitcnt vmcnt(5)
    buffer_load_dwordx4 v[136:139], v2, s[20:23], s59 offen offset:0 nt
    v_perm_b32 v60, v165, v157, s40
    v_perm_b32 v61, v181, v173, s40
    v_perm_b32 v62, v197, v189, s40
    v_perm_b32 v63, v213, v205, s40
    v_mfma_f32_16x16x32_bf16 v[72:75], v[56:59], v[40:43], v[72:75]
    v_perm_b32 v48, v166, v158, s39
    v_perm_b32 v49, v182, v174, s39
    v_perm_b32 v50, v198, v190, s39
    v_perm_b32 v51, v214, v206, s39
    v_mfma_f32_16x16x32_bf16 v[72:75], v[60:63], v[44:47], v[72:75]
    v_add_f32 v10, v16, v17
    v_add_f32 v11, v18, v19
    v_cvt_pk_bf16_f32 v28, v12, v13
    s_cbranch_vccnz L_s72
    s_waitcnt vmcnt(4)
L_s72:
    s_waitcnt vmcnt(5)
    buffer_load_dwordx4 v[140:143], v2, s[20:23], s59 offen offset:256 nt
    s_waitcnt lgkmcnt(0)
    v_readfirstlane_b32 s70, v223
    v_add_u32 v221, 1, v221
    s_cmp_eq_u32 s70, 1
    s_cselect_b64 vcc, -1, 0
    ds_write_b32 v222, v221
    ds_read_b32 v223, v222 offset:4
    v_perm_b32 v52, v166, v158, s40
    v_perm_b32 v53, v182, v174, s40
    v_perm_b32 v54, v198, v190, s40
    v_perm_b32 v55, v214, v206, s40
    v_mfma_f32_16x16x32_bf16 v[76:79], v[48:51], v[32:35], v[76:79]
    v_cvt_pk_bf16_f32 v29, v14, v15
    v_cvt_pk_bf16_f32 v30, v16, v17
    s_cbranch_vccnz L_s73
    s_waitcnt vmcnt(4)
L_s73:
    s_waitcnt vmcnt(5)
    buffer_load_dwordx4 v[144:147], v2, s[20:23], s59 offen offset:2048 nt
    v_perm_b32 v56, v167, v159, s39
    v_perm_b32 v57, v183, v175, s39
    v_perm_b32 v58, v199, v191, s39
    v_perm_b32 v59, v215, v207, s39
    v_mfma_f32_16x16x32_bf16 v[76:79], v[52:55], v[36:39], v[76:79]
    v_perm_b32 v60, v167, v159, s40
    v_perm_b32 v61, v183, v175, s40
    v_perm_b32 v62, v199, v191, s40
    v_perm_b32 v63, v215, v207, s40
    v_mfma_f32_16x16x32_bf16 v[76:79], v[56:59], v[40:43], v[76:79]
    v_cvt_pk_bf16_f32 v31, v18, v19
    v_add_f32 v8, v8, v9
    v_add_f32 v10, v10, v11
    s_cbranch_vccnz L_s74
    s_waitcnt vmcnt(4)
L_s74:
    s_waitcnt vmcnt(5)
    buffer_load_dwordx4 v[148:151], v2, s[20:23], s59 offen offset:2304 nt
    s_waitcnt lgkmcnt(0)
    v_readfirstlane_b32 s70, v223
    v_add_u32 v221, 1, v221
    s_cmp_eq_u32 s70, 1
    s_cselect_b64 vcc, -1, 0
    ds_write_b32 v222, v221
    ds_read_b32 v223, v222 offset:4
    v_mfma_f32_16x16x32_bf16 v[76:79], v[60:63], v[44:47], v[76:79]
    v_add_f32 v8, v8, v10
    v_add_f32 v4, v4, v8
    s_add_u32 s56, s56, 131072
    s_add_u32 s57, s57, 131072
    s_add_u32 s58, s58, 131072
    s_add_u32 s59, s59, 131072
    s_add_u32 s37, s37, 1
    s_cmp_lt_u32 s37, 7
    s_cbranch_scc1 L_vloop
    s_cbranch_vccnz L_s75
    s_waitcnt vmcnt(4)
L_s75:
    s_waitcnt vmcnt(5)
    buffer_load_dwordx4 v[152:155], v2, s[20:23], s56 offen offset:0 nt
    ds_read_b128 v[12:15], v217
    ds_read_b128 v[16:19], v217 offset:16
    v_add_u32 v217, 512, v217
    v_cndmask_b32_e64 v32, 0, v28, s[60:61]
    v_cndmask_b32_e64 v33, 0, v29, s[60:61]
    v_cndmask_b32_e64 v34, 0, v30, s[60:61]
    v_cndmask_b32_e64 v35, 0, v31, s[60:61]
    s_cbranch_vccnz L_s76
    s_waitcnt vmcnt(4)
L_s76:
    s_waitcnt vmcnt(5)
    buffer_load_dwordx4 v[160:163], v2, s[20:23], s56 offen offset:2048 nt
    s_waitcnt lgkmcnt(0)
    v_readfirstlane_b32 s70, v223
    v_add_u32 v221, 1, v221
    s_cmp_eq_u32 s70, 1
    s_cselect_b64 vcc, -1, 0
    ds_write_b32 v222, v221
    ds_read_b32 v223, v222 offset:4
    v_cndmask_b32_e64 v36, 0, v28, s[62:63]
    v_cndmask_b32_e64 v37, 0, v29, s[62:63]
    v_cndmask_b32_e64 v38, 0, v30, s[62:63]
    s_cbranch_vccnz L_s77
    s_waitcnt vmcnt(4)
L_s77:
    s_waitcnt vmcnt(5)
    buffer_load_dwordx4 v[168:171], v2, s[20:23], s57 offen offset:0 nt
    v_cndmask_b32_e64 v39, 0, v31, s[62:63]
    v_cndmask_b32_e64 v40, 0, v28, s[64:65]
    v_cndmask_b32_e64 v41, 0, v29, s[64:65]
    s_cbranch_vccnz L_s78
    s_waitcnt vmcnt(4)
L_s78:
    s_waitcnt vmcnt(5)
    buffer_load_dwordx4 v[176:179], v2, s[20:23], s57 offen offset:2048 nt
    s_waitcnt lgkmcnt(0)
    v_readfirstlane_b32 s70, v223
    v_add_u32 v221, 1, v221
    s_cmp_eq_u32 s70, 1
    s_cselect_b64 vcc, -1, 0
    ds_write_b32 v222, v221
    ds_read_b32 v223, v222 offset:4
    v_cndmask_b32_e64 v42, 0, v30, s[64:65]
    v_cndmask_b32_e64 v43, 0, v31, s[64:65]
    v_cndmask_b32_e64 v44, 0, v28, s[66:67]
    s_cbranch_vccnz L_s79
    s_waitcnt vmcnt(4)
L_s79:
    s_waitcnt vmcnt(5)
    buffer_load_dwordx4 v[184:187], v2, s[20:23], s58 offen offset:0 nt
    v_cndmask_b32_e64 v45, 0, v29, s[66:67]
    v_cndmask_b32_e64 v46, 0, v30, s[66:67]
    v_cndmask_b32_e64 v47, 0, v31, s[66:67]
    s_cbranch_vccnz L_s80
    s_waitcnt vmcnt(4)
L_s80:
    s_waitcnt vmcnt(5)
    buffer_load_dwordx4 v[192:195], v2, s[20:23], s58 offen offset:2048 nt
    s_waitcnt lgkmcnt(0)
    v_readfirstlane_b32 s70, v223
    v_add_u32 v221, 1, v221
    s_cmp_eq_u32 s70, 1
    s_cselect_b64 vcc, -1, 0
    ds_write_b32 v222, v221
    ds_read_b32 v223, v222 offset:4
    v_perm_b32 v48, v96, v88, s39
    v_perm_b32 v49, v112, v104, s39
    v_perm_b32 v50, v128, v120, s39
    v_perm_b32 v51, v144, v136, s39
    v_perm_b32 v52, v96, v88, s40
    v_perm_b32 v53, v112, v104, s40
    v_perm_b32 v54, v128, v120, s40
    v_perm_b32 v55, v144, v136, s40
    v_mfma_f32_16x16x32_bf16 v[64:67], v[48:51], v[32:35], v[64:67]
    s_waitcnt lgkmcnt(0)
    v_fma_f32 v12, v12, s38, -v218
    v_fma_f32 v13, v13, s38, -v218
    s_waitcnt vmcnt(9)
    buffer_load_dwordx4 v[200:203], v2, s[20:23], s59 offen offset:0 nt
    v_perm_b32 v56, v97, v89, s39
    v_perm_b32 v57, v113, v105, s39
    v_perm_b32 v58, v129, v121, s39
    v_perm_b32 v59, v145, v137, s39
    v_mfma_f32_16x16x32_bf16 v[64:67], v[52:55], v[36:39], v[64:67]
    v_perm_b32 v60, v97, v89, s40
    v_perm_b32 v61, v113, v105, s40
    v_perm_b32 v62, v129, v121, s40
    v_perm_b32 v63, v145, v137, s40
    v_mfma_f32_16x16x32_bf16 v[64:67], v[56:59], v[40:43], v[64:67]
    v_fma_f32 v14, v14, s38, -v218
    v_fma_f32 v15, v15, s38, -v218
    v_fma_f32 v16, v16, s38, -v218
    s_waitcnt vmcnt(9)
    buffer_load_dwordx4 v[208:211], v2, s[20:23], s59 offen offset:2048 nt
    s_waitcnt lgkmcnt(0)
    v_readfirstlane_b32 s70, v223
    v_add_u32 v221, 1, v221
    s_cmp_eq_u32 s70, 1
    s_cselect_b64 vcc, -1, 0
    ds_write_b32 v222, v221
    ds_read_b32 v223, v222 offset:4
    v_perm_b32 v48, v98, v90, s39
    v_perm_b32 v49, v114, v106, s39
    v_perm_b32 v50, v130, v122, s39
    v_perm_b32 v51, v146, v138, s39
    v_mfma_f32_16x16x32_bf16 v[64:67], v[60:63], v[44:47], v[64:67]
    v_fma_f32 v17, v17, s38, -v218
    v_fma_f32 v18, v18, s38, -v218
    s_waitcnt vmcnt(9)
    buffer_load_dwordx4 v[156:159], v2, s[20:23], s56 offen offset:256 nt
    v_perm_b32 v52, v98, v90, s40
    v_perm_b32 v53, v114, v106, s40
    v_perm_b32 v54, v130, v122, s40
    v_perm_b32 v55, v146, v138, s40
    v_mfma_f32_16x16x32_bf16 v[68:71], v[48:51], v[32:35], v[68:71]
    v_perm_b32 v56, v99, v91, s39
    v_perm_b32 v57, v115, v107, s39
    v_perm_b32 v58, v131, v123, s39
    v_perm_b32 v59, v147, v139, s39
    v_mfma_f32_16x16x32_bf16 v[68:71], v[52:55], v[36:39], v[68:71]
    v_fma_f32 v19, v19, s38, -v218
    v_exp_f32 v12, v12
    v_exp_f32 v13, v13
    s_waitcnt vmcnt(9)
    buffer_load_dwordx4 v[164:167], v2, s[20:23], s56 offen offset:2304 nt
    s_waitcnt lgkmcnt(0)
    v_readfirstlane_b32 s70, v223
    v_add_u32 v221, 1, v221
    s_cmp_eq_u32 s70, 1
    s_cselect_b64 vcc, -1, 0
    ds_write_b32 v222, v221
    ds_read_b32 v223, v222 offset:4
    v_perm_b32 v60, v99, v91, s40
    v_perm_b32 v61, v115, v107, s40
    v_perm_b32 v62, v131, v123, s40
    v_perm_b32 v63, v147, v139, s40
    v_mfma_f32_16x16x32_bf16 v[68:71], v[56:59], v[40:43], v[68:71]
    v_exp_f32 v14, v14
    v_exp_f32 v15, v15
    v_exp_f32 v16, v16
    s_waitcnt vmcnt(9)
    buffer_load_dwordx4 v[172:175], v2, s[20:23], s57 offen offset:256 nt
    v_perm_b32 v48, v100, v92, s39
    v_perm_b32 v49, v116, v108, s39
    v_perm_b32 v50, v132, v124, s39
    v_perm_b32 v51, v148, v140, s39
    v_mfma_f32_16x16x32_bf16 v[68:71], v[60:63], v[44:47], v[68:71]
    v_perm_b32 v52, v100, v92, s40
    v_perm_b32 v53, v116, v108, s40
    v_perm_b32 v54, v132, v124, s40
    v_perm_b32 v55, v148, v140, s40
    v_mfma_f32_16x16x32_bf16 v[72:75], v[48:51], v[32:35], v[72:75]
    v_exp_f32 v17, v17
    v_exp_f32 v18, v18
    s_waitcnt vmcnt(9)
    buffer_load_dwordx4 v[180:183], v2, s[20:23], s57 offen offset:2304 nt
    s_waitcnt lgkmcnt(0)
    v_readfirstlane_b32 s70, v223
    v_add_u32 v221, 1, v221
    s_cmp_eq_u32 s70, 1
    s_cselect_b64 vcc, -1, 0
    ds_write_b32 v222, v221
    ds_read_b32 v223, v222 offset:4
    v_perm_b32 v56, v101, v93, s39
    v_perm_b32 v57, v117, v109, s39
    v_perm_b32 v58, v133, v125, s39
    v_perm_b32 v59, v149, v141, s39
    v_mfma_f32_16x16x32_bf16 v[72:75], v[52:55], v[36:39], v[72:75]
    v_exp_f32 v19, v19
    v_add_f32 v8, v12, v13
    v_add_f32 v9, v14, v15
    s_waitcnt vmcnt(9)
    buffer_load_dwordx4 v[188:191], v2, s[20:23], s58 offen offset:256 nt
    v_perm_b32 v60, v101, v93, s40
    v_perm_b32 v61, v117, v109, s40
    v_perm_b32 v62, v133, v125, s40
    v_perm_b32 v63, v149, v141, s40
    v_mfma_f32_16x16x32_bf16 v[72:75], v[56:59], v[40:43], v[72:75]
    v_perm_b32 v48, v102, v94, s39
    v_perm_b32 v49, v118, v110, s39
    v_perm_b32 v50, v134, v126, s39
    v_perm_b32 v51, v150, v142, s39
    v_mfma_f32_16x16x32_bf16 v[72:75], v[60:63], v[44:47], v[72:75]
    v_add_f32 v10, v16, v17
    v_add_f32 v11, v18, v19
    v_cvt_pk_bf16_f32 v28, v12, v13
    s_waitcnt vmcnt(9)
    buffer_load_dwordx4 v[196:199], v2, s[20:23], s58 offen offset:2304 nt
    s_waitcnt lgkmcnt(0)
    v_readfirstlane_b32 s70, v223
    v_add_u32 v221, 1, v221
    s_cmp_eq_u32 s70, 1
    s_cselect_b64 vcc, -1, 0
    ds_write_b32 v222, v221
    ds_read_b32 v223, v222 offset:4
    v_perm_b32 v52, v102, v94, s40
    v_perm_b32 v53, v118, v110, s40
    v_perm_b32 v54, v134, v126, s40
    v_perm_b32 v55, v150, v142, s40
    v_mfma_f32_16x16x32_bf16 v[76:79], v[48:51], v[32:35], v[76:79]
    v_cvt_pk_bf16_f32 v29, v14, v15
    v_cvt_pk_bf16_f32 v30, v16, v17
    s_waitcnt vmcnt(9)
    buffer_load_dwordx4 v[204:207], v2, s[20:23], s59 offen offset:256 nt
    v_perm_b32 v56, v103, v95, s39
    v_perm_b32 v57, v119, v111, s39
    v_perm_b32 v58, v135, v127, s39
    v_perm_b32 v59, v151, v143, s39
    v_mfma_f32_16x16x32_bf16 v[76:79], v[52:55], v[36:39], v[76:79]
    v_perm_b32 v60, v103, v95, s40
    v_perm_b32 v61, v119, v111, s40
    v_perm_b32 v62, v135, v127, s40
    v_perm_b32 v63, v151, v143, s40
    v_mfma_f32_16x16x32_bf16 v[76:79], v[56:59], v[40:43], v[76:79]
    v_cvt_pk_bf16_f32 v31, v18, v19
    v_add_f32 v8, v8, v9
    v_add_f32 v10, v10, v11
    s_waitcnt vmcnt(9)
    buffer_load_dwordx4 v[212:215], v2, s[20:23], s59 offen offset:2304 nt
    v_mfma_f32_16x16x32_bf16 v[76:79], v[60:63], v[44:47], v[76:79]
    v_add_f32 v8, v8, v10
    v_add_f32 v4, v4, v8
    s_lshr_b32 s42, s41, 1
    s_lshl_b32 s42, s42, 2
    s_and_b32 s43, s41, 1
    s_lshl_b32 s43, s43, 4
    s_lshl_b32 s47, 1, s43
    v_mov_b32 v10, s42
    v_mov_b32 v11, s47
    s_waitcnt lgkmcnt(0)
    v_cndmask_b32_e64 v32, 0, v28, s[60:61]
    v_cndmask_b32_e64 v33, 0, v29, s[60:61]
    v_cndmask_b32_e64 v34, 0, v30, s[60:61]
    v_cndmask_b32_e64 v35, 0, v31, s[60:61]
    v_cndmask_b32_e64 v36, 0, v28, s[62:63]
    v_cndmask_b32_e64 v37, 0, v29, s[62:63]
    v_cndmask_b32_e64 v38, 0, v30, s[62:63]
    v_cndmask_b32_e64 v39, 0, v31, s[62:63]
    v_cndmask_b32_e64 v40, 0, v28, s[64:65]
    v_cndmask_b32_e64 v41, 0, v29, s[64:65]
    v_cndmask_b32_e64 v42, 0, v30, s[64:65]
    v_cndmask_b32_e64 v43, 0, v31, s[64:65]
    v_cndmask_b32_e64 v44, 0, v28, s[66:67]
    v_cndmask_b32_e64 v45, 0, v29, s[66:67]
    v_cndmask_b32_e64 v46, 0, v30, s[66:67]
    v_cndmask_b32_e64 v47, 0, v31, s[66:67]
    v_mov_b32 v5, v4
    s_nop 1
    v_permlane32_swap_b32 v4, v5
    v_add_f32 v4, v4, v5
    v_mov_b32 v5, v4
    s_nop 1
    v_permlane16_swap_b32 v4, v5
    v_add_f32 v4, v4, v5
    ds_write_b32 v219, v4 offset:128
    v_lshrrev_b32 v5, 3, v0
    v_lshlrev_b32 v5, 6, v5
    v_lshl_add_u32 v5, v0, 4, v5
    s_mul_i32 s42, s36, 1552
    v_add_u32 v5, s42, v5
    s_lshl_b32 s42, s36, 4
    v_mov_b32 v1, s42
    s_lshl_b32 s42, s41, 13
    s_add_u32 s42, s42, 0x10000
    s_add_u32 s32, s14, s42
    s_addc_u32 s33, s15, 0
    s_mov_b32 s34, 0x2000
    s_mov_b32 s35, 0x20000
    s_lshl_b32 s45, s36, 10
    v_lshl_add_u32 v6, v0, 4, s45
    s_lshl_b32 s45, s36, 7
    s_add_u32 s45, s45, 0x1000
    v_mov_b32 v8, s45
    s_lshl_b32 s46, s41, 11
    s_add_u32 s28, s10, s46
    s_addc_u32 s29, s11, 0
    s_mov_b32 s30, 0x800
    s_mov_b32 s31, 0x20000
    s_lshl_b32 s45, s36, 9
    v_lshl_add_u32 v2, v0, 3, s45
    s_waitcnt vmcnt(8)
    v_perm_b32 v48, v160, v152, s39
    v_perm_b32 v49, v176, v168, s39
    v_perm_b32 v50, v192, v184, s39
    v_perm_b32 v51, v208, v200, s39
    v_perm_b32 v52, v160, v152, s40
    v_perm_b32 v53, v176, v168, s40
    v_perm_b32 v54, v192, v184, s40
    v_perm_b32 v55, v208, v200, s40
    v_mfma_f32_16x16x32_bf16 v[64:67], v[48:51], v[32:35], v[64:67]
    v_perm_b32 v56, v161, v153, s39
    v_perm_b32 v57, v177, v169, s39
    v_perm_b32 v58, v193, v185, s39
    v_perm_b32 v59, v209, v201, s39
    v_mfma_f32_16x16x32_bf16 v[64:67], v[52:55], v[36:39], v[64:67]
    v_perm_b32 v60, v161, v153, s40
    v_perm_b32 v61, v177, v169, s40
    v_perm_b32 v62, v193, v185, s40
    v_perm_b32 v63, v209, v201, s40
    v_mfma_f32_16x16x32_bf16 v[64:67], v[56:59], v[40:43], v[64:67]
    v_perm_b32 v48, v162, v154, s39
    v_perm_b32 v49, v178, v170, s39
    v_perm_b32 v50, v194, v186, s39
    v_perm_b32 v51, v210, v202, s39
    v_mfma_f32_16x16x32_bf16 v[64:67], v[60:63], v[44:47], v[64:67]
    v_perm_b32 v52, v162, v154, s40
    v_perm_b32 v53, v178, v170, s40
    v_perm_b32 v54, v194, v186, s40
    v_perm_b32 v55, v210, v202, s40
    v_mfma_f32_16x16x32_bf16 v[68:71], v[48:51], v[32:35], v[68:71]
    v_perm_b32 v56, v163, v155, s39
    v_perm_b32 v57, v179, v171, s39
    v_perm_b32 v58, v195, v187, s39
    v_perm_b32 v59, v211, v203, s39
    v_mfma_f32_16x16x32_bf16 v[68:71], v[52:55], v[36:39], v[68:71]
    v_perm_b32 v60, v163, v155, s40
    v_perm_b32 v61, v179, v171, s40
    v_perm_b32 v62, v195, v187, s40
    v_perm_b32 v63, v211, v203, s40
    v_mfma_f32_16x16x32_bf16 v[68:71], v[56:59], v[40:43], v[68:71]
    s_nop 0
    v_mfma_f32_16x16x32_bf16 v[68:71], v[60:63], v[44:47], v[68:71]
    s_waitcnt vmcnt(0)
    v_mov_b32 v223, 0
    s_cmp_eq_u32 s49, 1
    s_cbranch_scc1 L_noclaim
    global_load_dword v223, v10, s[12:13] sc1
L_noclaim:
    v_perm_b32 v48, v164, v156, s39
    v_perm_b32 v49, v180, v172, s39
    v_perm_b32 v50, v196, v188, s39
    v_perm_b32 v51, v212, v204, s39
    v_perm_b32 v52, v164, v156, s40
    v_perm_b32 v53, v180, v172, s40
    v_perm_b32 v54, v196, v188, s40
    v_perm_b32 v55, v212, v204, s40
    v_mfma_f32_16x16x32_bf16 v[72:75], v[48:51], v[32:35], v[72:75]
    v_perm_b32 v56, v165, v157, s39
    v_perm_b32 v57, v181, v173, s39
    v_perm_b32 v58, v197, v189, s39
    v_perm_b32 v59, v213, v205, s39
    v_mfma_f32_16x16x32_bf16 v[72:75], v[52:55], v[36:39], v[72:75]
    ds_write_b32 v220, v64 offset:0
    ds_write_b32 v220, v65 offset:32
    ds_write_b32 v220, v66 offset:64
    ds_write_b32 v220, v67 offset:96
    v_perm_b32 v60, v165, v157, s40
    v_perm_b32 v61, v181, v173, s40
    v_perm_b32 v62, v197, v189, s40
    v_perm_b32 v63, v213, v205, s40
    v_mfma_f32_16x16x32_bf16 v[72:75], v[56:59], v[40:43], v[72:75]
    v_perm_b32 v48, v166, v158, s39
    v_perm_b32 v49, v182, v174, s39
    v_perm_b32 v50, v198, v190, s39
    v_perm_b32 v51, v214, v206, s39
    v_mfma_f32_16x16x32_bf16 v[72:75], v[60:63], v[44:47], v[72:75]
    ds_write_b32 v220, v68 offset:16
    ds_write_b32 v220, v69 offset:48
    ds_write_b32 v220, v70 offset:80
    ds_write_b32 v220, v71 offset:112
    v_perm_b32 v52, v166, v158, s40
    v_perm_b32 v53, v182, v174, s40
    v_perm_b32 v54, v198, v190, s40
    v_perm_b32 v55, v214, v206, s40
    v_mfma_f32_16x16x32_bf16 v[76:79], v[48:51], v[32:35], v[76:79]
    v_perm_b32 v56, v167, v159, s39
    v_perm_b32 v57, v183, v175, s39
    v_perm_b32 v58, v199, v191, s39
    v_perm_b32 v59, v215, v207, s39
    v_mfma_f32_16x16x32_bf16 v[76:79], v[52:55], v[36:39], v[76:79]
    v_perm_b32 v60, v167, v159, s40
    v_perm_b32 v61, v183, v175, s40
    v_perm_b32 v62, v199, v191, s40
    v_perm_b32 v63, v215, v207, s40
    v_mfma_f32_16x16x32_bf16 v[76:79], v[56:59], v[40:43], v[76:79]
    s_nop 0
    v_mfma_f32_16x16x32_bf16 v[76:79], v[60:63], v[44:47], v[76:79]
    ds_write_b32 v220, v72 offset:768
    ds_write_b32 v220, v73 offset:800
    ds_write_b32 v220, v74 offset:832
    ds_write_b32 v220, v75 offset:864
    s_nop 3
    ds_write_b32 v220, v76 offset:784
    ds_write_b32 v220, v77 offset:816
    ds_write_b32 v220, v78 offset:848
    ds_write_b32 v220, v79 offset:880
    s_waitcnt lgkmcnt(0)
    s_barrier
    ds_read_b128 v[32:35], v1 offset:64
    ds_read_b128 v[36:39], v1 offset:128
    ds_read_b128 v[88:91], v5 offset:256
    ds_read_b128 v[92:95], v5 offset:8448
    ds_read_b128 v[96:99], v5 offset:16640
    ds_read_b128 v[100:103], v5 offset:24832
    s_waitcnt vmcnt(0)
    v_readfirstlane_b32 s69, v223
    s_lshr_b32 s69, s69, s43
    s_and_b32 s69, s69, 0x100
    s_xor_b32 s42, s49, 1
    s_or_b32 s69, s69, s42
    s_bitcmp1_b32 s69, 8
    s_cbranch_scc0 L_nopre
    buffer_load_dwordx2 v[16:17], v8, s[32:35], 0 offen sc1
    buffer_load_dwordx4 v[12:15], v6, s[32:35], 0 offen sc1
L_nopre:
    s_waitcnt lgkmcnt(4)
    v_max3_f32 v68, v32, v33, v34
    v_max_f32 v68, v68, v35
    v_sub_f32 v32, v32, v68
    v_sub_f32 v33, v33, v68
    v_sub_f32 v34, v34, v68
    v_sub_f32 v35, v35, v68
    v_mul_f32 v32, s38, v32
    v_mul_f32 v33, s38, v33
    v_mul_f32 v34, s38, v34
    v_mul_f32 v35, s38, v35
    v_exp_f32 v32, v32
    v_exp_f32 v33, v33
    v_exp_f32 v34, v34
    v_exp_f32 v35, v35
    v_mul_f32 v69, v32, v36
    v_fmac_f32 v69, v33, v37
    v_fmac_f32 v69, v34, v38
    v_fmac_f32 v69, v35, v39
    s_waitcnt lgkmcnt(0)
    v_mul_f32 v64, v32, v88
    v_mul_f32 v65, v32, v89
    v_mul_f32 v66, v32, v90
    v_mul_f32 v67, v32, v91
    v_fmac_f32 v64, v33, v92
    v_fmac_f32 v65, v33, v93
    v_fmac_f32 v66, v33, v94
    v_fmac_f32 v67, v33, v95
    v_fmac_f32 v64, v34, v96
    v_fmac_f32 v65, v34, v97
    v_fmac_f32 v66, v34, v98
    v_fmac_f32 v67, v34, v99
    v_fmac_f32 v64, v35, v100
    v_fmac_f32 v65, v35, v101
    v_fmac_f32 v66, v35, v102
    v_fmac_f32 v67, v35, v103
    s_bitcmp1_b32 s69, 8
    s_cbranch_scc1 L_have
    s_and_b32 s42, s69, 0xff
    s_cbranch_scc1 L_poll
    buffer_store_dwordx4 v[64:67], v6, s[32:35], 0 offen sc1
    s_mov_b64 exec, 1
    buffer_store_dwordx2 v[68:69], v8, s[32:35], 0 offen sc1
    v_lshlrev_b32 v11, 8, v11
    s_waitcnt vmcnt(0)
    s_barrier
    s_cmp_lg_u32 s36, 0
    s_cbranch_scc1 L_fin
    global_atomic_or v10, v11, s[12:13]
    s_branch L_fin
L_poll:
    s_mov_b32 s44, 0
L_poll1:
    s_add_u32 s44, s44, 1
    s_cmp_gt_u32 s44, 0x200000
    s_cbranch_scc1 L_fin
    global_load_dword v12, v10, s[12:13] sc1
    s_waitcnt vmcnt(0)
    v_readfirstlane_b32 s42, v12
    s_lshr_b32 s42, s42, s43
    s_bitcmp1_b32 s42, 8
    s_cbranch_scc1 L_poll2
    s_sleep 2
    s_branch L_poll1
L_poll2:
    buffer_load_dwordx2 v[16:17], v8, s[32:35], 0 offen sc1
    buffer_load_dwordx4 v[12:15], v6, s[32:35], 0 offen sc1
L_have:
    s_waitcnt vmcnt(1)
    v_max_f32 v32, v68, v16
    v_sub_f32 v33, v68, v32
    v_sub_f32 v34, v16, v32
    v_mul_f32 v33, s38, v33
    v_mul_f32 v34, s38, v34
    v_exp_f32 v33, v33
    v_exp_f32 v34, v34
    v_mul_f32 v35, v69, v33
    v_mul_f32 v32, v17, v34
    v_add_f32 v35, v35, v32
    v_rcp_f32 v35, v35
    v_mul_f32 v64, v64, v33
    v_mul_f32 v65, v65, v33
    v_mul_f32 v66, v66, v33
    v_mul_f32 v67, v67, v33
    s_waitcnt vmcnt(0)
    v_mul_f32 v12, v12, v34
    v_mul_f32 v13, v13, v34
    v_mul_f32 v14, v14, v34
    v_mul_f32 v15, v15, v34
    v_add_f32 v64, v64, v12
    v_add_f32 v65, v65, v13
    v_add_f32 v66, v66, v14
    v_add_f32 v67, v67, v15
    v_mul_f32 v64, v64, v35
    v_mul_f32 v65, v65, v35
    v_mul_f32 v66, v66, v35
    v_mul_f32 v67, v67, v35
    v_cvt_pk_bf16_f32 v10, v64, v65
    v_cvt_pk_bf16_f32 v11, v66, v67
    buffer_store_dwordx2 v[10:11], v2, s[28:31], 0 offen
L_fin:
    s_endpgm
L_helper:
    v_and_b32 v2, 3, v0
    v_lshlrev_b32 v2, 4, v2
    v_mov_b32 v4, 0
    v_mov_b32 v5, 0
    ds_write_b64 v2, v[4:5]
    s_and_b32 s45, s2, 7
    s_lshl_b32 s45, s45, 8
    v_and_b32 v9, 31, v0
    v_lshl_add_u32 v9, v9, 2, s45
    s_lshr_b32 s47, s2, 3
    s_lshl_b32 s46, s47, 2
    s_add_u32 s46, s46, s45
    v_mov_b32 v10, s46
    s_waitcnt lgkmcnt(0)
    global_load_dword v18, v9, s[14:15] nt
    s_barrier
    s_waitcnt vmcnt(0)
    v_readlane_b32 s48, v18, s47
L_h:
    s_sleep 6
    ds_read_b32 v16, v2
    s_waitcnt lgkmcnt(0)
    v_readlane_b32 s60, v16, 0
    v_readlane_b32 s61, v16, 1
    v_readlane_b32 s62, v16, 2
    v_readlane_b32 s63, v16, 3
    s_add_u32 s57, s60, s61
    s_add_u32 s58, s62, s63
    s_add_u32 s57, s57, s58
    s_cmp_lt_u32 s57, 64
    s_cbranch_scc1 L_h
    s_cmp_ge_u32 s57, 1000
    s_cselect_b32 s58, 2048, s57
    s_add_u32 s58, s58, s48
    v_mov_b32 v16, s58
    s_mov_b64 exec, 1
    global_store_dword v10, v16, s[14:15]
    s_mov_b64 exec, -1
    s_cmp_ge_u32 s57, 1000
    s_cbranch_scc1 L_end
    global_load_dword v17, v9, s[14:15] nt
    s_lshl_b32 s60, s60, 2
    s_lshl_b32 s61, s61, 2
    s_lshl_b32 s62, s62, 2
    s_lshl_b32 s63, s63, 2
    s_waitcnt vmcnt(0)
    v_sub_u32 v17, v17, v18
    v_cmp_lt_u32 s[58:59], s60, v17
    s_bcnt1_i32_b32 s58, s58
    s_cmp_ge_u32 s58, 10
    s_cselect_b32 s58, 1, 0
    v_writelane_b32 v19, s58, 0
    v_cmp_lt_u32 s[58:59], s61, v17
    s_bcnt1_i32_b32 s58, s58
    s_cmp_ge_u32 s58, 10
    s_cselect_b32 s58, 1, 0
    v_writelane_b32 v19, s58, 1
    v_cmp_lt_u32 s[58:59], s62, v17
    s_bcnt1_i32_b32 s58, s58
    s_cmp_ge_u32 s58, 10
    s_cselect_b32 s58, 1, 0
    v_writelane_b32 v19, s58, 2
    v_cmp_lt_u32 s[58:59], s63, v17
    s_bcnt1_i32_b32 s58, s58
    s_cmp_ge_u32 s58, 10
    s_cselect_b32 s58, 1, 0
    v_writelane_b32 v19, s58, 3
    s_mov_b64 exec, 15
    ds_write_b32 v2, v19 offset:4
    s_mov_b64 exec, -1
    s_branch L_h
L_end:
    s_endpgm
.section .rodata,"a"
.p2align 6
.amdhsa_kernel standalone__mha_softmax__sampling_kernel
  .amdhsa_next_free_vgpr 232
  .amdhsa_next_free_sgpr 72
  .amdhsa_accum_offset 232
  .amdhsa_group_segment_fixed_size 0
  .amdhsa_kernarg_size 48
  .amdhsa_user_sgpr_count 2
  .amdhsa_user_sgpr_kernarg_segment_ptr 1
  .amdhsa_system_sgpr_workgroup_id_x 1
.end_amdhsa_kernel
```
